```python
import torch

def _softmax(x, axis=-1):
    return torch.softmax(x, dim=axis)
def _gelu(x):
    return torch.nn.functional.gelu(x, approximate="tanh")
def _silu(x):
    return torch.nn.functional.silu(x)
def _sigmoid(x):
    return torch.sigmoid(x)
def _layernorm(x, axis=-1, eps=1e-5):
    m = x.mean(dim=axis, keepdim=True)
    v = x.var(dim=axis, keepdim=True, unbiased=False)
    return (x - m) / torch.sqrt(v + eps)
def _scatter_add(tgt, idx, src, axis=0):
    return tgt.clone().index_add_(axis, idx, src)
def _segment_sum(src, seg, n):
    out = torch.zeros((n,) + src.shape[1:], dtype=src.dtype)
    return out.index_add_(0, seg, src)
def _pad(x, pw):
    flat = tuple(v for pair in reversed(pw) for v in pair)
    return torch.nn.functional.pad(x, flat)

kernel_name = 'standalone__grn__sampling'

def setup_inputs():

    _w = (lambda a: (lambda t: t.to(torch.bfloat16) if t.is_floating_point() else t)(torch.as_tensor(a)))
    B, S, D = 1024, 16, 448
    return {
        "x": _w((lambda *s: torch.randn(*s, dtype=torch.bfloat16) * 0.05)(B, S, D)),
        "g": _w((lambda *s: torch.randn(*s, dtype=torch.bfloat16) * 0.4)(D) * 0.1),
        "b": _w((lambda *s: torch.randn(*s, dtype=torch.bfloat16) * 0.1)(D) * 0.1),
    }

def reference(x, g, b):
    gx = torch.sqrt((x * x).sum(axis=-2, keepdims=True))
    nx = gx / (gx.mean(axis=-1, keepdims=True) + 1e-6)
    return g * (x * nx) + b + x
```

```asm
; @launch grid=(256,1,1) block=(256,1,1) lds=0
.amdgcn_target "amdgcn-amd-amdhsa--gfx950"
.text
.globl standalone__grn__sampling_kernel
.p2align 8
.type standalone__grn__sampling_kernel,@function
standalone__grn__sampling_kernel:
    s_load_dwordx8 s[4:11], s[0:1], 0
    s_cmpk_ge_u32 s2, 256
    s_cbranch_scc1 L_done
    v_lshrrev_b32 v1, 6, v0
    v_and_b32 v3, 63, v0
    s_lshl_b32 s3, s2, 2
    v_add_u32 v1, s3, v1
    v_mul_u32_u24 v1, 14336, v1
    v_lshlrev_b32 v3, 4, v3
    v_add_u32 v1, v1, v3
    v_add_u32 v2, 11648, v1
    v_add_u32 v1, 3584, v1
    v_mov_b32 v0, 0
    s_bfm_b32 exec_hi, 24, 0
    s_waitcnt lgkmcnt(0)
    global_load_dwordx4 v[40:43], v1, s[4:5] offset:-3584 nt
    global_load_dwordx4 v[48:51], v1, s[4:5] offset:-2688 nt
    global_load_dwordx4 v[56:59], v1, s[4:5] offset:-1792 nt
    global_load_dwordx4 v[64:67], v1, s[4:5] offset:-896 nt
    global_load_dwordx4 v[4:7], v3, s[6:7]
    global_load_dwordx4 v[8:11], v3, s[8:9]
    global_load_dwordx4 v[72:75], v1, s[4:5] offset:0 nt
    global_load_dwordx4 v[80:83], v1, s[4:5] offset:896 nt
    global_load_dwordx4 v[88:91], v1, s[4:5] offset:1792 nt
    global_load_dwordx4 v[96:99], v1, s[4:5] offset:2688 nt
    global_load_dwordx4 v[104:107], v1, s[4:5] offset:3584 nt
    global_load_dwordx4 v[112:115], v2, s[4:5] offset:-3584 nt
    global_load_dwordx4 v[120:123], v2, s[4:5] offset:-2688 nt
    global_load_dwordx4 v[128:131], v2, s[4:5] offset:-1792 nt
    global_load_dwordx4 v[136:139], v2, s[4:5] offset:-896 nt
    global_load_dwordx4 v[144:147], v2, s[4:5] offset:0 nt
    global_load_dwordx4 v[152:155], v2, s[4:5] offset:896 nt
    global_load_dwordx4 v[160:163], v2, s[4:5] offset:1792 nt
    s_mov_b32 s12, 0xffff0000
    v_mov_b32 v164, 0x3b124925
    v_mov_b32 v165, 0x358637bd
    s_waitcnt vmcnt(17)
    v_lshlrev_b32 v36, 16, v40
    v_and_b32 v37, s12, v40
    v_lshlrev_b32 v38, 16, v41
    v_and_b32 v39, s12, v41
    v_lshlrev_b32 v40, 16, v42
    v_and_b32 v41, s12, v42
    v_lshlrev_b32 v42, 16, v43
    v_and_b32 v43, s12, v43
    v_pk_mul_f32 v[12:13], v[36:37], v[36:37]
    v_pk_mul_f32 v[14:15], v[38:39], v[38:39]
    v_pk_mul_f32 v[16:17], v[40:41], v[40:41]
    v_pk_mul_f32 v[18:19], v[42:43], v[42:43]
    s_waitcnt vmcnt(16)
    v_lshlrev_b32 v44, 16, v48
    v_and_b32 v45, s12, v48
    v_lshlrev_b32 v46, 16, v49
    v_and_b32 v47, s12, v49
    v_lshlrev_b32 v48, 16, v50
    v_and_b32 v49, s12, v50
    v_lshlrev_b32 v50, 16, v51
    v_and_b32 v51, s12, v51
    v_pk_fma_f32 v[12:13], v[44:45], v[44:45], v[12:13]
    v_pk_fma_f32 v[14:15], v[46:47], v[46:47], v[14:15]
    v_pk_fma_f32 v[16:17], v[48:49], v[48:49], v[16:17]
    v_pk_fma_f32 v[18:19], v[50:51], v[50:51], v[18:19]
    s_waitcnt vmcnt(15)
    v_lshlrev_b32 v52, 16, v56
    v_and_b32 v53, s12, v56
    v_lshlrev_b32 v54, 16, v57
    v_and_b32 v55, s12, v57
    v_lshlrev_b32 v56, 16, v58
    v_and_b32 v57, s12, v58
    v_lshlrev_b32 v58, 16, v59
    v_and_b32 v59, s12, v59
    v_pk_fma_f32 v[12:13], v[52:53], v[52:53], v[12:13]
    v_pk_fma_f32 v[14:15], v[54:55], v[54:55], v[14:15]
    v_pk_fma_f32 v[16:17], v[56:57], v[56:57], v[16:17]
    v_pk_fma_f32 v[18:19], v[58:59], v[58:59], v[18:19]
    s_waitcnt vmcnt(14)
    v_lshlrev_b32 v60, 16, v64
    v_and_b32 v61, s12, v64
    v_lshlrev_b32 v62, 16, v65
    v_and_b32 v63, s12, v65
    v_lshlrev_b32 v64, 16, v66
    v_and_b32 v65, s12, v66
    v_lshlrev_b32 v66, 16, v67
    v_and_b32 v67, s12, v67
    v_pk_fma_f32 v[12:13], v[60:61], v[60:61], v[12:13]
    v_pk_fma_f32 v[14:15], v[62:63], v[62:63], v[14:15]
    v_pk_fma_f32 v[16:17], v[64:65], v[64:65], v[16:17]
    v_pk_fma_f32 v[18:19], v[66:67], v[66:67], v[18:19]
    s_waitcnt vmcnt(12)
    v_lshlrev_b32 v20, 16, v4
    v_and_b32 v21, s12, v4
    v_lshlrev_b32 v22, 16, v5
    v_and_b32 v23, s12, v5
    v_lshlrev_b32 v24, 16, v6
    v_and_b32 v25, s12, v6
    v_lshlrev_b32 v26, 16, v7
    v_and_b32 v27, s12, v7
    v_lshlrev_b32 v28, 16, v8
    v_and_b32 v29, s12, v8
    v_lshlrev_b32 v30, 16, v9
    v_and_b32 v31, s12, v9
    v_lshlrev_b32 v32, 16, v10
    v_and_b32 v33, s12, v10
    v_lshlrev_b32 v34, 16, v11
    v_and_b32 v35, s12, v11
    s_waitcnt vmcnt(11)
    v_lshlrev_b32 v68, 16, v72
    v_and_b32 v69, s12, v72
    v_lshlrev_b32 v70, 16, v73
    v_and_b32 v71, s12, v73
    v_lshlrev_b32 v72, 16, v74
    v_and_b32 v73, s12, v74
    v_lshlrev_b32 v74, 16, v75
    v_and_b32 v75, s12, v75
    v_pk_fma_f32 v[12:13], v[68:69], v[68:69], v[12:13]
    v_pk_fma_f32 v[14:15], v[70:71], v[70:71], v[14:15]
    v_pk_fma_f32 v[16:17], v[72:73], v[72:73], v[16:17]
    v_pk_fma_f32 v[18:19], v[74:75], v[74:75], v[18:19]
    s_waitcnt vmcnt(10)
    v_lshlrev_b32 v76, 16, v80
    v_and_b32 v77, s12, v80
    v_lshlrev_b32 v78, 16, v81
    v_and_b32 v79, s12, v81
    v_lshlrev_b32 v80, 16, v82
    v_and_b32 v81, s12, v82
    v_lshlrev_b32 v82, 16, v83
    v_and_b32 v83, s12, v83
    v_pk_fma_f32 v[12:13], v[76:77], v[76:77], v[12:13]
    v_pk_fma_f32 v[14:15], v[78:79], v[78:79], v[14:15]
    v_pk_fma_f32 v[16:17], v[80:81], v[80:81], v[16:17]
    v_pk_fma_f32 v[18:19], v[82:83], v[82:83], v[18:19]
    s_waitcnt vmcnt(9)
    v_lshlrev_b32 v84, 16, v88
    v_and_b32 v85, s12, v88
    v_lshlrev_b32 v86, 16, v89
    v_and_b32 v87, s12, v89
    v_lshlrev_b32 v88, 16, v90
    v_and_b32 v89, s12, v90
    v_lshlrev_b32 v90, 16, v91
    v_and_b32 v91, s12, v91
    v_pk_fma_f32 v[12:13], v[84:85], v[84:85], v[12:13]
    v_pk_fma_f32 v[14:15], v[86:87], v[86:87], v[14:15]
    v_pk_fma_f32 v[16:17], v[88:89], v[88:89], v[16:17]
    v_pk_fma_f32 v[18:19], v[90:91], v[90:91], v[18:19]
    s_waitcnt vmcnt(8)
    v_lshlrev_b32 v92, 16, v96
    v_and_b32 v93, s12, v96
    v_lshlrev_b32 v94, 16, v97
    v_and_b32 v95, s12, v97
    v_lshlrev_b32 v96, 16, v98
    v_and_b32 v97, s12, v98
    v_lshlrev_b32 v98, 16, v99
    v_and_b32 v99, s12, v99
    v_pk_fma_f32 v[12:13], v[92:93], v[92:93], v[12:13]
    v_pk_fma_f32 v[14:15], v[94:95], v[94:95], v[14:15]
    v_pk_fma_f32 v[16:17], v[96:97], v[96:97], v[16:17]
    v_pk_fma_f32 v[18:19], v[98:99], v[98:99], v[18:19]
    s_waitcnt vmcnt(7)
    v_lshlrev_b32 v100, 16, v104
    v_and_b32 v101, s12, v104
    v_lshlrev_b32 v102, 16, v105
    v_and_b32 v103, s12, v105
    v_lshlrev_b32 v104, 16, v106
    v_and_b32 v105, s12, v106
    v_lshlrev_b32 v106, 16, v107
    v_and_b32 v107, s12, v107
    v_pk_fma_f32 v[12:13], v[100:101], v[100:101], v[12:13]
    v_pk_fma_f32 v[14:15], v[102:103], v[102:103], v[14:15]
    v_pk_fma_f32 v[16:17], v[104:105], v[104:105], v[16:17]
    v_pk_fma_f32 v[18:19], v[106:107], v[106:107], v[18:19]
    s_waitcnt vmcnt(6)
    v_lshlrev_b32 v108, 16, v112
    v_and_b32 v109, s12, v112
    v_lshlrev_b32 v110, 16, v113
    v_and_b32 v111, s12, v113
    v_lshlrev_b32 v112, 16, v114
    v_and_b32 v113, s12, v114
    v_lshlrev_b32 v114, 16, v115
    v_and_b32 v115, s12, v115
    v_pk_fma_f32 v[12:13], v[108:109], v[108:109], v[12:13]
    v_pk_fma_f32 v[14:15], v[110:111], v[110:111], v[14:15]
    v_pk_fma_f32 v[16:17], v[112:113], v[112:113], v[16:17]
    v_pk_fma_f32 v[18:19], v[114:115], v[114:115], v[18:19]
    s_waitcnt vmcnt(5)
    v_lshlrev_b32 v116, 16, v120
    v_and_b32 v117, s12, v120
    v_lshlrev_b32 v118, 16, v121
    v_and_b32 v119, s12, v121
    v_lshlrev_b32 v120, 16, v122
    v_and_b32 v121, s12, v122
    v_lshlrev_b32 v122, 16, v123
    v_and_b32 v123, s12, v123
    v_pk_fma_f32 v[12:13], v[116:117], v[116:117], v[12:13]
    v_pk_fma_f32 v[14:15], v[118:119], v[118:119], v[14:15]
    v_pk_fma_f32 v[16:17], v[120:121], v[120:121], v[16:17]
    v_pk_fma_f32 v[18:19], v[122:123], v[122:123], v[18:19]
    s_waitcnt vmcnt(4)
    v_lshlrev_b32 v124, 16, v128
    v_and_b32 v125, s12, v128
    v_lshlrev_b32 v126, 16, v129
    v_and_b32 v127, s12, v129
    v_lshlrev_b32 v128, 16, v130
    v_and_b32 v129, s12, v130
    v_lshlrev_b32 v130, 16, v131
    v_and_b32 v131, s12, v131
    v_pk_fma_f32 v[12:13], v[124:125], v[124:125], v[12:13]
    v_pk_fma_f32 v[14:15], v[126:127], v[126:127], v[14:15]
    v_pk_fma_f32 v[16:17], v[128:129], v[128:129], v[16:17]
    v_pk_fma_f32 v[18:19], v[130:131], v[130:131], v[18:19]
    s_waitcnt vmcnt(3)
    v_lshlrev_b32 v132, 16, v136
    v_and_b32 v133, s12, v136
    v_lshlrev_b32 v134, 16, v137
    v_and_b32 v135, s12, v137
    v_lshlrev_b32 v136, 16, v138
    v_and_b32 v137, s12, v138
    v_lshlrev_b32 v138, 16, v139
    v_and_b32 v139, s12, v139
    v_pk_fma_f32 v[12:13], v[132:133], v[132:133], v[12:13]
    v_pk_fma_f32 v[14:15], v[134:135], v[134:135], v[14:15]
    v_pk_fma_f32 v[16:17], v[136:137], v[136:137], v[16:17]
    v_pk_fma_f32 v[18:19], v[138:139], v[138:139], v[18:19]
    s_waitcnt vmcnt(2)
    v_lshlrev_b32 v140, 16, v144
    v_and_b32 v141, s12, v144
    v_lshlrev_b32 v142, 16, v145
    v_and_b32 v143, s12, v145
    v_lshlrev_b32 v144, 16, v146
    v_and_b32 v145, s12, v146
    v_lshlrev_b32 v146, 16, v147
    v_and_b32 v147, s12, v147
    v_pk_fma_f32 v[12:13], v[140:141], v[140:141], v[12:13]
    v_pk_fma_f32 v[14:15], v[142:143], v[142:143], v[14:15]
    v_pk_fma_f32 v[16:17], v[144:145], v[144:145], v[16:17]
    v_pk_fma_f32 v[18:19], v[146:147], v[146:147], v[18:19]
    s_waitcnt vmcnt(1)
    v_lshlrev_b32 v148, 16, v152
    v_and_b32 v149, s12, v152
    v_lshlrev_b32 v150, 16, v153
    v_and_b32 v151, s12, v153
    v_lshlrev_b32 v152, 16, v154
    v_and_b32 v153, s12, v154
    v_lshlrev_b32 v154, 16, v155
    v_and_b32 v155, s12, v155
    v_pk_fma_f32 v[12:13], v[148:149], v[148:149], v[12:13]
    v_pk_fma_f32 v[14:15], v[150:151], v[150:151], v[14:15]
    v_pk_fma_f32 v[16:17], v[152:153], v[152:153], v[16:17]
    v_pk_fma_f32 v[18:19], v[154:155], v[154:155], v[18:19]
    s_waitcnt vmcnt(0)
    v_lshlrev_b32 v156, 16, v160
    v_and_b32 v157, s12, v160
    v_lshlrev_b32 v158, 16, v161
    v_and_b32 v159, s12, v161
    v_lshlrev_b32 v160, 16, v162
    v_and_b32 v161, s12, v162
    v_lshlrev_b32 v162, 16, v163
    v_and_b32 v163, s12, v163
    v_pk_fma_f32 v[12:13], v[156:157], v[156:157], v[12:13]
    v_pk_fma_f32 v[14:15], v[158:159], v[158:159], v[14:15]
    v_pk_fma_f32 v[16:17], v[160:161], v[160:161], v[16:17]
    v_pk_fma_f32 v[18:19], v[162:163], v[162:163], v[18:19]
    v_sqrt_f32 v12, v12
    v_sqrt_f32 v13, v13
    v_sqrt_f32 v14, v14
    v_sqrt_f32 v15, v15
    v_sqrt_f32 v16, v16
    v_sqrt_f32 v17, v17
    v_sqrt_f32 v18, v18
    v_sqrt_f32 v19, v19
    s_nop 0
    v_pk_add_f32 v[4:5], v[12:13], v[14:15]
    v_pk_add_f32 v[6:7], v[16:17], v[18:19]
    v_pk_mul_f32 v[20:21], v[20:21], v[12:13]
    v_pk_add_f32 v[4:5], v[4:5], v[6:7]
    v_pk_mul_f32 v[22:23], v[22:23], v[14:15]
    v_add_f32 v0, v4, v5
    s_mov_b32 exec_hi, -1
    s_nop 1
    v_add_f32_dpp v0, v0, v0 row_shr:1 row_mask:0xf bank_mask:0xf bound_ctrl:0
    s_nop 1
    v_add_f32_dpp v0, v0, v0 row_shr:2 row_mask:0xf bank_mask:0xf bound_ctrl:0
    s_nop 1
    v_add_f32_dpp v0, v0, v0 row_shr:4 row_mask:0xf bank_mask:0xf bound_ctrl:0
    s_nop 1
    v_add_f32_dpp v0, v0, v0 row_shr:8 row_mask:0xf bank_mask:0xf bound_ctrl:0
    s_nop 1
    v_add_f32_dpp v0, v0, v0 row_bcast:15 row_mask:0xa bank_mask:0xf
    s_nop 1
    v_add_f32_dpp v0, v0, v0 row_bcast:31 row_mask:0xc bank_mask:0xf
    s_nop 1
    v_readlane_b32 s13, v0, 63
    s_bfm_b32 exec_hi, 24, 0
    v_pk_mul_f32 v[24:25], v[24:25], v[16:17]
    v_pk_mul_f32 v[26:27], v[26:27], v[18:19]
    v_fma_f32 v4, s13, v164, v165
    v_rcp_f32 v4, v4
    s_nop 0
    v_pk_fma_f32 v[20:21], v[20:21], v[4:5], 1.0 op_sel_hi:[1,0,0]
    v_pk_fma_f32 v[22:23], v[22:23], v[4:5], 1.0 op_sel_hi:[1,0,0]
    v_pk_fma_f32 v[24:25], v[24:25], v[4:5], 1.0 op_sel_hi:[1,0,0]
    v_pk_fma_f32 v[26:27], v[26:27], v[4:5], 1.0 op_sel_hi:[1,0,0]
    v_pk_fma_f32 v[36:37], v[36:37], v[20:21], v[28:29]
    v_pk_fma_f32 v[38:39], v[38:39], v[22:23], v[30:31]
    v_pk_fma_f32 v[40:41], v[40:41], v[24:25], v[32:33]
    v_pk_fma_f32 v[42:43], v[42:43], v[26:27], v[34:35]
    v_cvt_pk_bf16_f32 v36, v36, v37
    v_cvt_pk_bf16_f32 v37, v38, v39
    v_cvt_pk_bf16_f32 v38, v40, v41
    v_cvt_pk_bf16_f32 v39, v42, v43
    global_store_dwordx4 v1, v[36:39], s[10:11] offset:-3584 sc1 nt
    v_pk_fma_f32 v[44:45], v[44:45], v[20:21], v[28:29]
    v_pk_fma_f32 v[46:47], v[46:47], v[22:23], v[30:31]
    v_pk_fma_f32 v[48:49], v[48:49], v[24:25], v[32:33]
    v_pk_fma_f32 v[50:51], v[50:51], v[26:27], v[34:35]
    v_cvt_pk_bf16_f32 v44, v44, v45
    v_cvt_pk_bf16_f32 v45, v46, v47
    v_cvt_pk_bf16_f32 v46, v48, v49
    v_cvt_pk_bf16_f32 v47, v50, v51
    global_store_dwordx4 v1, v[44:47], s[10:11] offset:-2688 sc1 nt
    v_pk_fma_f32 v[52:53], v[52:53], v[20:21], v[28:29]
    v_pk_fma_f32 v[54:55], v[54:55], v[22:23], v[30:31]
    v_pk_fma_f32 v[56:57], v[56:57], v[24:25], v[32:33]
    v_pk_fma_f32 v[58:59], v[58:59], v[26:27], v[34:35]
    v_cvt_pk_bf16_f32 v52, v52, v53
    v_cvt_pk_bf16_f32 v53, v54, v55
    v_cvt_pk_bf16_f32 v54, v56, v57
    v_cvt_pk_bf16_f32 v55, v58, v59
    global_store_dwordx4 v1, v[52:55], s[10:11] offset:-1792 sc1 nt
    v_pk_fma_f32 v[60:61], v[60:61], v[20:21], v[28:29]
    v_pk_fma_f32 v[62:63], v[62:63], v[22:23], v[30:31]
    v_pk_fma_f32 v[64:65], v[64:65], v[24:25], v[32:33]
    v_pk_fma_f32 v[66:67], v[66:67], v[26:27], v[34:35]
    v_cvt_pk_bf16_f32 v60, v60, v61
    v_cvt_pk_bf16_f32 v61, v62, v63
    v_cvt_pk_bf16_f32 v62, v64, v65
    v_cvt_pk_bf16_f32 v63, v66, v67
    global_store_dwordx4 v1, v[60:63], s[10:11] offset:-896 sc1 nt
    v_pk_fma_f32 v[68:69], v[68:69], v[20:21], v[28:29]
    v_pk_fma_f32 v[70:71], v[70:71], v[22:23], v[30:31]
    v_pk_fma_f32 v[72:73], v[72:73], v[24:25], v[32:33]
    v_pk_fma_f32 v[74:75], v[74:75], v[26:27], v[34:35]
    v_cvt_pk_bf16_f32 v68, v68, v69
    v_cvt_pk_bf16_f32 v69, v70, v71
    v_cvt_pk_bf16_f32 v70, v72, v73
    v_cvt_pk_bf16_f32 v71, v74, v75
    global_store_dwordx4 v1, v[68:71], s[10:11] offset:0 sc1 nt
    v_pk_fma_f32 v[76:77], v[76:77], v[20:21], v[28:29]
    v_pk_fma_f32 v[78:79], v[78:79], v[22:23], v[30:31]
    v_pk_fma_f32 v[80:81], v[80:81], v[24:25], v[32:33]
    v_pk_fma_f32 v[82:83], v[82:83], v[26:27], v[34:35]
    v_cvt_pk_bf16_f32 v76, v76, v77
    v_cvt_pk_bf16_f32 v77, v78, v79
    v_cvt_pk_bf16_f32 v78, v80, v81
    v_cvt_pk_bf16_f32 v79, v82, v83
    global_store_dwordx4 v1, v[76:79], s[10:11] offset:896 sc1 nt
    v_pk_fma_f32 v[84:85], v[84:85], v[20:21], v[28:29]
    v_pk_fma_f32 v[86:87], v[86:87], v[22:23], v[30:31]
    v_pk_fma_f32 v[88:89], v[88:89], v[24:25], v[32:33]
    v_pk_fma_f32 v[90:91], v[90:91], v[26:27], v[34:35]
    v_cvt_pk_bf16_f32 v84, v84, v85
    v_cvt_pk_bf16_f32 v85, v86, v87
    v_cvt_pk_bf16_f32 v86, v88, v89
    v_cvt_pk_bf16_f32 v87, v90, v91
    global_store_dwordx4 v1, v[84:87], s[10:11] offset:1792 sc1 nt
    v_pk_fma_f32 v[92:93], v[92:93], v[20:21], v[28:29]
    v_pk_fma_f32 v[94:95], v[94:95], v[22:23], v[30:31]
    v_pk_fma_f32 v[96:97], v[96:97], v[24:25], v[32:33]
    v_pk_fma_f32 v[98:99], v[98:99], v[26:27], v[34:35]
    v_cvt_pk_bf16_f32 v92, v92, v93
    v_cvt_pk_bf16_f32 v93, v94, v95
    v_cvt_pk_bf16_f32 v94, v96, v97
    v_cvt_pk_bf16_f32 v95, v98, v99
    global_store_dwordx4 v1, v[92:95], s[10:11] offset:2688 sc1 nt
    v_pk_fma_f32 v[100:101], v[100:101], v[20:21], v[28:29]
    v_pk_fma_f32 v[102:103], v[102:103], v[22:23], v[30:31]
    v_pk_fma_f32 v[104:105], v[104:105], v[24:25], v[32:33]
    v_pk_fma_f32 v[106:107], v[106:107], v[26:27], v[34:35]
    v_cvt_pk_bf16_f32 v100, v100, v101
    v_cvt_pk_bf16_f32 v101, v102, v103
    v_cvt_pk_bf16_f32 v102, v104, v105
    v_cvt_pk_bf16_f32 v103, v106, v107
    global_store_dwordx4 v1, v[100:103], s[10:11] offset:3584 sc1 nt
    v_pk_fma_f32 v[108:109], v[108:109], v[20:21], v[28:29]
    v_pk_fma_f32 v[110:111], v[110:111], v[22:23], v[30:31]
    v_pk_fma_f32 v[112:113], v[112:113], v[24:25], v[32:33]
    v_pk_fma_f32 v[114:115], v[114:115], v[26:27], v[34:35]
    v_cvt_pk_bf16_f32 v108, v108, v109
    v_cvt_pk_bf16_f32 v109, v110, v111
    v_cvt_pk_bf16_f32 v110, v112, v113
    v_cvt_pk_bf16_f32 v111, v114, v115
    global_store_dwordx4 v2, v[108:111], s[10:11] offset:-3584 sc1 nt
    v_pk_fma_f32 v[116:117], v[116:117], v[20:21], v[28:29]
    v_pk_fma_f32 v[118:119], v[118:119], v[22:23], v[30:31]
    v_pk_fma_f32 v[120:121], v[120:121], v[24:25], v[32:33]
    v_pk_fma_f32 v[122:123], v[122:123], v[26:27], v[34:35]
    v_cvt_pk_bf16_f32 v116, v116, v117
    v_cvt_pk_bf16_f32 v117, v118, v119
    v_cvt_pk_bf16_f32 v118, v120, v121
    v_cvt_pk_bf16_f32 v119, v122, v123
    global_store_dwordx4 v2, v[116:119], s[10:11] offset:-2688 sc1 nt
    v_pk_fma_f32 v[124:125], v[124:125], v[20:21], v[28:29]
    v_pk_fma_f32 v[126:127], v[126:127], v[22:23], v[30:31]
    v_pk_fma_f32 v[128:129], v[128:129], v[24:25], v[32:33]
    v_pk_fma_f32 v[130:131], v[130:131], v[26:27], v[34:35]
    v_cvt_pk_bf16_f32 v124, v124, v125
    v_cvt_pk_bf16_f32 v125, v126, v127
    v_cvt_pk_bf16_f32 v126, v128, v129
    v_cvt_pk_bf16_f32 v127, v130, v131
    global_store_dwordx4 v2, v[124:127], s[10:11] offset:-1792 sc1 nt
    v_pk_fma_f32 v[132:133], v[132:133], v[20:21], v[28:29]
    v_pk_fma_f32 v[134:135], v[134:135], v[22:23], v[30:31]
    v_pk_fma_f32 v[136:137], v[136:137], v[24:25], v[32:33]
    v_pk_fma_f32 v[138:139], v[138:139], v[26:27], v[34:35]
    v_cvt_pk_bf16_f32 v132, v132, v133
    v_cvt_pk_bf16_f32 v133, v134, v135
    v_cvt_pk_bf16_f32 v134, v136, v137
    v_cvt_pk_bf16_f32 v135, v138, v139
    global_store_dwordx4 v2, v[132:135], s[10:11] offset:-896 sc1 nt
    v_pk_fma_f32 v[140:141], v[140:141], v[20:21], v[28:29]
    v_pk_fma_f32 v[142:143], v[142:143], v[22:23], v[30:31]
    v_pk_fma_f32 v[144:145], v[144:145], v[24:25], v[32:33]
    v_pk_fma_f32 v[146:147], v[146:147], v[26:27], v[34:35]
    v_cvt_pk_bf16_f32 v140, v140, v141
    v_cvt_pk_bf16_f32 v141, v142, v143
    v_cvt_pk_bf16_f32 v142, v144, v145
    v_cvt_pk_bf16_f32 v143, v146, v147
    global_store_dwordx4 v2, v[140:143], s[10:11] offset:0 sc1 nt
    v_pk_fma_f32 v[148:149], v[148:149], v[20:21], v[28:29]
    v_pk_fma_f32 v[150:151], v[150:151], v[22:23], v[30:31]
    v_pk_fma_f32 v[152:153], v[152:153], v[24:25], v[32:33]
    v_pk_fma_f32 v[154:155], v[154:155], v[26:27], v[34:35]
    v_cvt_pk_bf16_f32 v148, v148, v149
    v_cvt_pk_bf16_f32 v149, v150, v151
    v_cvt_pk_bf16_f32 v150, v152, v153
    v_cvt_pk_bf16_f32 v151, v154, v155
    global_store_dwordx4 v2, v[148:151], s[10:11] offset:896 sc1 nt
    v_pk_fma_f32 v[156:157], v[156:157], v[20:21], v[28:29]
    v_pk_fma_f32 v[158:159], v[158:159], v[22:23], v[30:31]
    v_pk_fma_f32 v[160:161], v[160:161], v[24:25], v[32:33]
    v_pk_fma_f32 v[162:163], v[162:163], v[26:27], v[34:35]
    v_cvt_pk_bf16_f32 v156, v156, v157
    v_cvt_pk_bf16_f32 v157, v158, v159
    v_cvt_pk_bf16_f32 v158, v160, v161
    v_cvt_pk_bf16_f32 v159, v162, v163
    global_store_dwordx4 v2, v[156:159], s[10:11] offset:1792 sc1 nt
L_done:
    s_endpgm
.section .rodata,"a"
.p2align 6
.amdhsa_kernel standalone__grn__sampling_kernel
  .amdhsa_next_free_vgpr 166
  .amdhsa_next_free_sgpr 32
  .amdhsa_accum_offset 168
  .amdhsa_group_segment_fixed_size 0
  .amdhsa_kernarg_size 48
  .amdhsa_user_sgpr_count 2
  .amdhsa_user_sgpr_kernarg_segment_ptr 1
  .amdhsa_system_sgpr_workgroup_id_x 1
  .amdhsa_float_denorm_mode_32 3
.end_amdhsa_kernel
```
